```python
import torch

def _softmax(x, axis=-1):
    return torch.softmax(x, dim=axis)
def _gelu(x):
    return torch.nn.functional.gelu(x, approximate="tanh")
def _silu(x):
    return torch.nn.functional.silu(x)
def _sigmoid(x):
    return torch.sigmoid(x)
def _layernorm(x, axis=-1, eps=1e-5):
    m = x.mean(dim=axis, keepdim=True)
    v = x.var(dim=axis, keepdim=True, unbiased=False)
    return (x - m) / torch.sqrt(v + eps)
def _scatter_add(tgt, idx, src, axis=0):
    return tgt.clone().index_add_(axis, idx, src)
def _segment_sum(src, seg, n):
    out = torch.zeros((n,) + src.shape[1:], dtype=src.dtype)
    return out.index_add_(0, seg, src)
def _pad(x, pw):
    flat = tuple(v for pair in reversed(pw) for v in pair)
    return torch.nn.functional.pad(x, flat)

kernel_name = 'recurrent_scan__gqa_block_cached__mixer_channel_mlp__decode'

def setup_inputs():

    _w = (lambda a: (lambda t: t.to(torch.bfloat16) if t.is_floating_point() else t)(torch.as_tensor(a)))
    def _A_setup():
        B, Sq, D = 2, 1, 1024
        Hq, Hkv, Sk, Dh = 32, 4, 16384, 128
        assert Hq % Hkv == 0, (Hq, Hkv)
        return {
            "x": _w((lambda *s: torch.randn(*s, dtype=torch.bfloat16) * 0.1)(B, Sq, D)),
            "k_cache": _w((lambda *s: torch.randn(*s, dtype=torch.bfloat16) * 0.8)(B, Hkv, Sk, Dh)),
            "v_cache": _w((lambda *s: torch.randn(*s, dtype=torch.bfloat16) * 3.2)(B, Hkv, Sk, Dh)),
            "wq": _w((lambda *s: torch.randn(*s, dtype=torch.bfloat16) * 0.8)(D, Hq * Dh) * (D ** -0.5)),
            "wo": _w((lambda *s: torch.randn(*s, dtype=torch.bfloat16) * 3.2)(Hq * Dh, D) * ((Hq * Dh) ** -0.5)),
        }
    _A_in = _A_setup()

    def _B_setup():
        B, S, D, F = 2, 1, 1024, 3584
        return {
            "x": _w((lambda *s: torch.randn(*s, dtype=torch.bfloat16) * 0.1)(B, S, D)),
            "w1": _w((lambda *s: torch.randn(*s, dtype=torch.bfloat16) * 3.2)(D, F) * (D ** -0.5)),
            "b1": _w((lambda *s: torch.randn(*s, dtype=torch.bfloat16) * 3.2)(F)),
            "w2": _w((lambda *s: torch.randn(*s, dtype=torch.bfloat16) * 3.2)(F, D) * (F ** -0.5)),
            "b2": _w((lambda *s: torch.randn(*s, dtype=torch.bfloat16) * 3.2)(D)),
        }
    _B_in = _B_setup()

    return {
        "A_x": _A_in["x"],
        "A_k_cache": _A_in["k_cache"],
        "A_v_cache": _A_in["v_cache"],
        "A_wq": _A_in["wq"],
        "A_wo": _A_in["wo"],
        "B_x": _B_in["x"],
        "B_w1": _B_in["w1"],
        "B_b1": _B_in["b1"],
        "B_w2": _B_in["w2"],
        "B_b2": _B_in["b2"],
    }

def reference(A_x, A_k_cache, A_v_cache, A_wq, A_wo, B_x, B_w1, B_b1, B_w2, B_b2):
    def _A_ref(x, k_cache, v_cache, wq, wo):
        B, Sq, D = x.shape
        Hq, Dh = 32, 128
        Hkv = k_cache.shape[1]
        rep = Hq // Hkv
        q = (lambda x, *d: x.permute(*d))((x @ wq).reshape(B, Sq, Hq, Dh), 0, 2, 1, 3)
        k = (lambda x, n, axis: torch.repeat_interleave(x, n, dim=axis))(k_cache, rep, axis=1)
        v = (lambda x, n, axis: torch.repeat_interleave(x, n, dim=axis))(v_cache, rep, axis=1)
        scores = torch.einsum("bhqd,bhkd->bhqk", q, k) * (Dh ** -0.5)
        p = _softmax(scores, axis=-1)
        o = torch.einsum("bhqk,bhkd->bhqd", p, v)
        return (lambda x, *d: x.permute(*d))(o, 0, 2, 1, 3).reshape(B, Sq, Hq * Dh) @ wo

    def _B_ref(x, w1, b1, w2, b2):
        y = _layernorm(x, axis=-1)
        h = _gelu(torch.einsum("bsd,df->bsf", y, w1) + b1)
        return torch.einsum("bsf,fd->bsd", h, w2) + b2

    x = A_x
    xn = _layernorm(x, axis=-1)
    s = _A_ref(xn, A_k_cache, A_v_cache, A_wq, A_wo)
    g = _silu(_B_ref(xn, B_w1, B_b1, B_w2, B_b2))
    return x + s * g
```

```asm
; @launch grid=(256,1,1) block=(512,1,1) lds=82432
.amdgcn_target "amdgcn-amd-amdhsa--gfx950"
.text
.globl recurrent_scan__gqa_block_cached__mixer_channel_mlp__decode_kernel
.p2align 8
.type recurrent_scan__gqa_block_cached__mixer_channel_mlp__decode_kernel,@function
recurrent_scan__gqa_block_cached__mixer_channel_mlp__decode_kernel:
    s_load_dwordx2 s[16:17], s[0:1], 24
    s_load_dwordx2 s[8:9], s[0:1], 0
    s_cmp_ge_u32 s2, 256
    s_cbranch_scc1 L_end
    s_load_dwordx2 s[20:21], s[0:1], 48
    s_load_dwordx2 s[32:33], s[0:1], 32
    s_load_dwordx2 s[24:25], s[0:1], 8
    s_load_dwordx2 s[12:13], s[0:1], 96
    v_lshrrev_b32 v48, 6, v0
    v_and_b32 v1, 63, v0
    v_readfirstlane_b32 s3, v48
    s_and_b32 s4, s2, 7
    s_lshr_b32 s5, s2, 3
    v_lshrrev_b32 v2, 4, v1
    v_bfe_u32 v52, v1, 3, 1
    v_lshlrev_b32 v52, 4, v52
    v_lshl_add_u32 v52, v2, 2, v52
    v_and_b32 v53, 7, v1
    v_lshlrev_b32 v53, 4, v53
    v_lshl_add_u32 v6, v52, 13, v53
    s_lshr_b32 s65, s4, 1
    s_lshl_b32 s65, s65, 3
    s_add_u32 s65, s65, s3
    s_lshl_b32 s65, s65, 5
    s_and_b32 s6, s2, 1
    s_lshl_b32 s59, s6, 5
    s_add_u32 s59, s59, s5
    s_lshl_b32 s55, s65, 6
    s_add_u32 s55, s55, s59
    s_lshl_b32 s55, s55, 7
    v_lshlrev_b32 v4, 3, v0
    v_lshrrev_b32 v5, 8, v0
    v_lshlrev_b32 v5, 11, v5
    s_mov_b32 s18, 0x800000
    s_mov_b32 s19, 0x20000
    s_mov_b32 s10, 0x1000
    s_mov_b32 s11, 0x20000
    s_waitcnt lgkmcnt(0)
    buffer_load_dwordx2 v[12:13], v4, s[8:11], 0 offen
    buffer_load_ushort v14, v5, s[8:11], 0 offen
    buffer_load_dwordx4 v[192:195], v6, s[16:19], s55 offen nt
    s_add_u32 s55, s55, 8192
    buffer_load_dwordx4 v[196:199], v6, s[16:19], s55 offen nt
    s_add_u32 s55, s55, 8192
    buffer_load_dwordx4 v[200:203], v6, s[16:19], s55 offen nt
    s_add_u32 s55, s55, 8192
    buffer_load_dwordx4 v[204:207], v6, s[16:19], s55 offen nt
    s_getpc_b64 s[66:67]
    v_lshlrev_b32 v49, 7, v0
    v_cmp_gt_u32 vcc, 67, v0
    s_nop 0
    s_and_saveexec_b64 s[68:69], vcc
    s_cbranch_execz L_nopf
    global_load_dword v17, v49, s[66:67]
L_nopf:
    s_mov_b64 exec, s[68:69]
    v_mul_u32_u24 v7, 7168, v52
    v_add_u32 v7, v7, v53
    s_mov_b32 s23, 0x20000
    v_and_b32 v3, 15, v1
    v_lshlrev_b32 v49, 4, v3
    v_lshl_add_u32 v23, v2, 11, v49
    s_add_u32 s73, s5, 4
    s_lshr_b32 s73, s73, 3
    s_sub_u32 s73, s5, s73
    s_lshr_b32 s6, s5, 3
    s_add_u32 s6, s6, 28
    s_and_b32 s7, s5, 7
    s_cmp_eq_u32 s7, 3
    s_cselect_b32 s73, s6, s73
    s_lshl_b32 s79, s4, 2
    s_lshr_b32 s79, 0x76243501, s79
    s_and_b32 s79, s79, 7
    s_and_b32 s6, s2, 1
    s_mul_i32 s6, s6, 28
    s_add_u32 s6, s6, s73
    s_sub_u32 s7, s6, 7
    s_add_u32 s60, s7, 4
    s_mul_i32 s60, s60, 37
    s_lshr_b32 s60, s60, 8
    s_add_u32 s60, s60, s7
    s_lshl_b32 s7, s6, 3
    s_add_u32 s7, s7, 3
    s_cmp_lt_u32 s6, 7
    s_cselect_b32 s60, s7, s60
    s_mul_i32 s56, s65, 56
    s_add_u32 s56, s56, s60
    s_lshl_b32 s56, s56, 7
    s_lshl_b32 s6, s5, 3
    s_add_u32 s6, s6, s3
    s_lshr_b32 s6, s6, 1
    s_lshl_b32 s6, s6, 3
    s_and_b32 s7, s3, 1
    s_add_u32 s6, s6, s7
    s_lshl_b32 s6, s6, 5
    s_add_u32 s6, s6, s79
    s_lshl_b32 s71, s6, 8
    s_movk_i32 s61, 7168
    s_mov_b32 s22, 0x700000
    s_cmp_lt_u32 s73, 28
    s_cbranch_scc1 L_nothub0
    s_mov_b32 s20, s32
    s_mov_b32 s21, s33
    s_mov_b32 s22, 0x800000
    s_mov_b32 s56, s71
    s_movk_i32 s61, 16384
    v_mov_b32 v7, v23
L_nothub0:
    buffer_load_dwordx4 v[208:211], v7, s[20:23], s56 offen nt
    s_add_u32 s56, s56, s61
    buffer_load_dwordx4 v[212:215], v7, s[20:23], s56 offen nt
    s_add_u32 s56, s56, s61
    s_lshl_b32 s57, s4, 22
    s_lshl_b32 s7, s5, 17
    s_add_u32 s57, s57, s7
    s_lshl_b32 s7, s3, 14
    s_add_u32 s57, s57, s7
    s_add_u32 s58, s57, 4096
    v_bfe_u32 v48, v1, 1, 1
    v_lshlrev_b32 v8, 13, v48
    v_bfe_u32 v48, v1, 2, 2
    v_lshl_add_u32 v8, v48, 8, v8
    v_and_b32 v48, 1, v1
    v_lshl_add_u32 v8, v48, 6, v8
    v_lshl_add_u32 v8, v2, 4, v8
    v_mov_b32 v51, 0
    s_mov_b32 s26, 0x2000000
    s_mov_b32 s27, 0x20000
    s_mov_b32 s14, 0x10000000
    s_mov_b32 s15, 0x20000
    buffer_load_dword v15, v51, s[12:15], 0 offen sc1
    s_load_dwordx2 s[28:29], s[0:1], 16
    s_load_dwordx2 s[36:37], s[0:1], 64
    s_load_dwordx2 s[44:45], s[0:1], 72
    s_load_dwordx2 s[48:49], s[0:1], 80
    s_load_dwordx2 s[40:41], s[0:1], 56
    s_mov_b32 s30, 0x2000000
    s_mov_b32 s31, 0x20000
    s_mov_b32 s34, 0x800000
    s_mov_b32 s35, 0x20000
    s_mov_b32 s38, 0x700000
    s_mov_b32 s39, 0x20000
    s_mov_b32 s46, 0x800
    s_mov_b32 s47, 0x20000
    s_mov_b32 s50, 0x1000
    s_mov_b32 s51, 0x20000
    s_mov_b32 s42, 0x1c00
    s_mov_b32 s43, 0x20000
    v_lshlrev_b32 v9, 4, v1
    s_mov_b32 s53, 0x05040100
    s_mov_b32 s54, 0x07060302
    s_mov_b32 s64, 0x3fb8aa3b
    v_mov_b32 v48, 0xff800000
    v_and_b32 v49, 7, v1
    v_lshlrev_b32 v49, 2, v49
    ds_write_b32 v49, v48 offset:8320
    v_lshlrev_b32 v49, 4, v3
    v_lshl_add_u32 v10, v2, 13, v49
    s_lshl_b32 s6, s4, 5
    s_add_u32 s6, s6, s5
    s_lshl_b32 s6, s6, 3
    s_add_u32 s6, s6, s3
    s_lshl_b32 s6, s6, 9
    s_add_u32 s6, s6, 1048576
    v_and_b32 v53, 3, v1
    v_lshlrev_b32 v53, 7, v53
    v_bfe_u32 v54, v1, 2, 1
    v_lshl_add_u32 v53, v54, 20, v53
    v_add_u32 v53, s6, v53
    s_lshl_b32 s6, s4, 6
    s_add_u32 s6, s6, s5
    s_lshl_b32 s6, s6, 3
    s_add_u32 s6, s6, s3
    s_lshl_b32 s6, s6, 7
    s_add_u32 s6, s6, 3145728
    v_writelane_b32 v53, s6, 8
    s_add_u32 s6, s6, 0x8000
    v_writelane_b32 v53, s6, 9
    s_mov_b64 exec, 0x3ff
    buffer_load_dword v17, v53, s[12:15], 0 offen sc1
    s_mov_b64 exec, -1
    v_lshrrev_b32 v58, 6, v0
    v_lshlrev_b32 v58, 3, v58
    v_lshrrev_b32 v59, 8, v0
    v_lshlrev_b32 v59, 5, v59
    s_waitcnt vmcnt(8)
    v_lshlrev_b32 v48, 16, v12
    v_and_b32 v49, 0xffff0000, v12
    v_lshlrev_b32 v50, 16, v13
    v_and_b32 v51, 0xffff0000, v13
    v_lshlrev_b32 v14, 16, v14
    v_sub_f32 v52, v48, v14
    v_sub_f32 v53, v49, v14
    v_sub_f32 v54, v50, v14
    v_sub_f32 v55, v51, v14
    v_add_f32 v56, v52, v53
    v_mul_f32 v57, v52, v52
    v_add_f32 v56, v56, v54
    v_fmac_f32 v57, v53, v53
    v_add_f32 v56, v56, v55
    v_fmac_f32 v57, v54, v54
    v_fmac_f32 v57, v55, v55
    v_add_f32_dpp v56, v56, v56 row_ror:8 row_mask:0xf bank_mask:0xf
    s_nop 0
    v_add_f32_dpp v57, v57, v57 row_ror:8 row_mask:0xf bank_mask:0xf
    v_add_f32_dpp v56, v56, v56 row_ror:4 row_mask:0xf bank_mask:0xf
    s_nop 0
    v_add_f32_dpp v57, v57, v57 row_ror:4 row_mask:0xf bank_mask:0xf
    v_add_f32_dpp v56, v56, v56 row_ror:2 row_mask:0xf bank_mask:0xf
    s_nop 0
    v_add_f32_dpp v57, v57, v57 row_ror:2 row_mask:0xf bank_mask:0xf
    v_add_f32_dpp v56, v56, v56 row_ror:1 row_mask:0xf bank_mask:0xf
    s_nop 0
    v_add_f32_dpp v57, v57, v57 row_ror:1 row_mask:0xf bank_mask:0xf
    v_add_f32_dpp v56, v56, v56 row_bcast:15 row_mask:0xa bank_mask:0xf
    s_nop 0
    v_add_f32_dpp v57, v57, v57 row_bcast:15 row_mask:0xa bank_mask:0xf
    v_add_f32_dpp v56, v56, v56 row_bcast:31 row_mask:0xc bank_mask:0xf
    s_nop 0
    v_add_f32_dpp v57, v57, v57 row_bcast:31 row_mask:0xc bank_mask:0xf
    s_mov_b32 exec_lo, 0
    s_mov_b32 exec_hi, 0x80000000
    ds_write_b64 v58, v[56:57] offset:8192
    s_mov_b64 exec, -1
    s_waitcnt vmcnt(7)
    buffer_load_dwordx4 v[216:219], v7, s[20:23], s56 offen nt
    s_add_u32 s56, s56, s61
    s_waitcnt lgkmcnt(0)
    s_barrier
    ds_read_b128 v[224:227], v59 offset:8192
    ds_read_b128 v[228:231], v59 offset:8208
    s_waitcnt lgkmcnt(0)
    v_add_f32 v224, v224, v226
    v_add_f32 v225, v225, v227
    v_add_f32 v228, v228, v230
    v_add_f32 v229, v229, v231
    v_add_f32 v56, v224, v228
    v_add_f32 v57, v225, v229
    v_mul_f32 v56, 0x3a800000, v56
    v_mul_f32 v57, 0x3a800000, v57
    v_fma_f32 v57, -v56, v56, v57
    v_max_f32 v57, 0, v57
    v_add_f32 v56, v56, v14
    v_cvt_pk_bf16_f32 v57, v57, v57
    v_and_b32 v57, 0xffff0000, v57
    v_cvt_pk_bf16_f32 v56, v56, v56
    v_and_b32 v56, 0xffff0000, v56
    v_add_f32 v57, 0x3727c5ac, v57
    v_cvt_pk_bf16_f32 v57, v57, v57
    v_and_b32 v57, 0xffff0000, v57
    v_sqrt_f32 v57, v57
    v_sub_f32 v52, v48, v56
    v_sub_f32 v53, v49, v56
    v_sub_f32 v54, v50, v56
    v_sub_f32 v55, v51, v56
    v_cvt_pk_bf16_f32 v57, v57, v57
    v_and_b32 v57, 0xffff0000, v57
    v_rcp_f32 v57, v57
    v_cvt_pk_bf16_f32 v224, v52, v53
    v_cvt_pk_bf16_f32 v225, v54, v55
    v_lshlrev_b32 v52, 16, v224
    v_and_b32 v53, 0xffff0000, v224
    v_lshlrev_b32 v54, 16, v225
    v_and_b32 v55, 0xffff0000, v225
    v_mul_f32 v52, v52, v57
    v_mul_f32 v53, v53, v57
    v_mul_f32 v54, v54, v57
    v_mul_f32 v55, v55, v57
    v_cvt_pk_bf16_f32 v12, v52, v53
    v_cvt_pk_bf16_f32 v13, v54, v55
    ds_write_b64 v4, v[12:13] offset:0
    s_waitcnt vmcnt(7)
    buffer_load_dwordx4 v[220:223], v7, s[20:23], s56 offen nt
    v_lshrrev_b32 v58, 6, v0
    v_lshlrev_b32 v58, 3, v58
    v_lshrrev_b32 v59, 8, v0
    v_lshlrev_b32 v59, 5, v59
    v_lshlrev_b32 v48, 16, v12
    v_and_b32 v49, 0xffff0000, v12
    v_lshlrev_b32 v50, 16, v13
    v_and_b32 v51, 0xffff0000, v13
    v_add_f32 v56, v48, v49
    v_mul_f32 v57, v48, v48
    v_add_f32 v56, v56, v50
    v_fmac_f32 v57, v49, v49
    v_add_f32 v56, v56, v51
    v_fmac_f32 v57, v50, v50
    v_fmac_f32 v57, v51, v51
    v_add_f32_dpp v56, v56, v56 row_ror:8 row_mask:0xf bank_mask:0xf
    s_nop 0
    v_add_f32_dpp v57, v57, v57 row_ror:8 row_mask:0xf bank_mask:0xf
    v_add_f32_dpp v56, v56, v56 row_ror:4 row_mask:0xf bank_mask:0xf
    s_nop 0
    v_add_f32_dpp v57, v57, v57 row_ror:4 row_mask:0xf bank_mask:0xf
    v_add_f32_dpp v56, v56, v56 row_ror:2 row_mask:0xf bank_mask:0xf
    s_nop 0
    v_add_f32_dpp v57, v57, v57 row_ror:2 row_mask:0xf bank_mask:0xf
    v_add_f32_dpp v56, v56, v56 row_ror:1 row_mask:0xf bank_mask:0xf
    s_nop 0
    v_add_f32_dpp v57, v57, v57 row_ror:1 row_mask:0xf bank_mask:0xf
    v_add_f32_dpp v56, v56, v56 row_bcast:15 row_mask:0xa bank_mask:0xf
    s_nop 0
    v_add_f32_dpp v57, v57, v57 row_bcast:15 row_mask:0xa bank_mask:0xf
    v_add_f32_dpp v56, v56, v56 row_bcast:31 row_mask:0xc bank_mask:0xf
    s_nop 0
    v_add_f32_dpp v57, v57, v57 row_bcast:31 row_mask:0xc bank_mask:0xf
    s_mov_b32 exec_lo, 0
    s_mov_b32 exec_hi, 0x80000000
    ds_write_b64 v58, v[56:57] offset:8256
    s_mov_b64 exec, -1
    s_waitcnt vmcnt(7)
    buffer_load_dwordx4 v[64:67], v8, s[24:27], s57 offen offset:0 nt
    s_waitcnt lgkmcnt(0)
    s_barrier
    ds_read_b128 v[224:227], v59 offset:8256
    ds_read_b128 v[228:231], v59 offset:8272
    s_waitcnt lgkmcnt(0)
    v_add_f32 v224, v224, v226
    v_add_f32 v225, v225, v227
    v_add_f32 v228, v228, v230
    v_add_f32 v229, v229, v231
    v_add_f32 v56, v224, v228
    v_add_f32 v57, v225, v229
    v_mul_f32 v56, 0x3a800000, v56
    v_mul_f32 v57, 0x3a800000, v57
    v_fma_f32 v57, -v56, v56, v57
    v_max_f32 v57, 0, v57
    v_cvt_pk_bf16_f32 v57, v57, v57
    v_and_b32 v57, 0xffff0000, v57
    v_cvt_pk_bf16_f32 v56, v56, v56
    v_and_b32 v56, 0xffff0000, v56
    v_add_f32 v57, 0x3727c5ac, v57
    v_cvt_pk_bf16_f32 v57, v57, v57
    v_and_b32 v57, 0xffff0000, v57
    v_sqrt_f32 v57, v57
    v_sub_f32 v52, v48, v56
    v_sub_f32 v53, v49, v56
    v_sub_f32 v54, v50, v56
    v_sub_f32 v55, v51, v56
    v_cvt_pk_bf16_f32 v57, v57, v57
    v_and_b32 v57, 0xffff0000, v57
    v_rcp_f32 v57, v57
    v_cvt_pk_bf16_f32 v224, v52, v53
    v_cvt_pk_bf16_f32 v225, v54, v55
    v_lshlrev_b32 v52, 16, v224
    v_and_b32 v53, 0xffff0000, v224
    v_lshlrev_b32 v54, 16, v225
    v_and_b32 v55, 0xffff0000, v225
    v_mul_f32 v52, v52, v57
    v_mul_f32 v53, v53, v57
    v_mul_f32 v54, v54, v57
    v_mul_f32 v55, v55, v57
    v_cvt_pk_bf16_f32 v12, v52, v53
    v_cvt_pk_bf16_f32 v13, v54, v55
    ds_write_b64 v4, v[12:13] offset:4096
    v_and_b32 v60, 1, v1
    v_lshlrev_b32 v60, 11, v60
    v_bfe_u32 v49, v1, 2, 1
    v_lshl_add_u32 v60, v49, 5, v60
    v_lshl_add_u32 v60, v2, 3, v60
    v_bfe_u32 v61, v1, 3, 1
    v_mul_u32_u24 v61, 576, v61
    v_and_b32 v50, 7, v1
    v_lshl_add_u32 v61, v50, 5, v61
    s_mul_i32 s6, s3, 1152
    s_add_u32 s6, s6, 12288
    v_add_u32 v61, s6, v61
    s_lshl_b32 s6, s65, 1
    v_add_u32 v48, s6, v60
    v_add_u32 v52, 9216, v61
    s_waitcnt vmcnt(7)
    buffer_load_dwordx4 v[68:71], v8, s[24:27], s57 offen offset:128 nt
    s_waitcnt lgkmcnt(0)
    s_barrier
    ds_read_b64 v[32:33], v48 offset:0
    ds_read_b64 v[34:35], v48 offset:4096
    v_perm_b32 v176, v196, v192, s53
    v_perm_b32 v178, v196, v192, s54
    v_perm_b32 v180, v197, v193, s53
    v_perm_b32 v182, v197, v193, s54
    v_perm_b32 v184, v198, v194, s53
    v_perm_b32 v186, v198, v194, s54
    v_perm_b32 v188, v199, v195, s53
    v_perm_b32 v190, v199, v195, s54
    v_perm_b32 v177, v204, v200, s53
    v_perm_b32 v179, v204, v200, s54
    v_perm_b32 v181, v205, v201, s53
    v_perm_b32 v183, v205, v201, s54
    v_perm_b32 v185, v206, v202, s53
    v_perm_b32 v187, v206, v202, s54
    v_perm_b32 v189, v207, v203, s53
    v_perm_b32 v191, v207, v203, s54
    s_waitcnt lgkmcnt(0)
    v_mfma_f32_16x16x16_bf16 v[224:227], v[32:33], v[176:177], 0
    v_mfma_f32_16x16x16_bf16 v[228:231], v[32:33], v[178:179], 0
    v_mfma_f32_16x16x16_bf16 v[232:235], v[32:33], v[180:181], 0
    v_mfma_f32_16x16x16_bf16 v[236:239], v[32:33], v[182:183], 0
    v_mfma_f32_16x16x16_bf16 v[240:243], v[32:33], v[184:185], 0
    v_mfma_f32_16x16x16_bf16 v[244:247], v[32:33], v[186:187], 0
    v_mfma_f32_16x16x16_bf16 v[248:251], v[32:33], v[188:189], 0
    v_mfma_f32_16x16x16_bf16 v[252:255], v[32:33], v[190:191], 0
    s_mov_b64 exec, 0xff0000ff
    ds_write2_b32 v61, v224, v225 offset0:0 offset1:64
    ds_write2_b32 v61, v228, v229 offset0:1 offset1:65
    ds_write2_b32 v61, v232, v233 offset0:2 offset1:66
    ds_write2_b32 v61, v236, v237 offset0:3 offset1:67
    ds_write2_b32 v61, v240, v241 offset0:4 offset1:68
    ds_write2_b32 v61, v244, v245 offset0:5 offset1:69
    ds_write2_b32 v61, v248, v249 offset0:6 offset1:70
    ds_write2_b32 v61, v252, v253 offset0:7 offset1:71
    s_mov_b64 exec, -1
    s_waitcnt vmcnt(7)
    buffer_load_dwordx4 v[72:75], v8, s[24:27], s57 offen offset:1024 nt
    s_waitcnt vmcnt(7)
    v_perm_b32 v176, v212, v208, s53
    v_perm_b32 v178, v212, v208, s54
    v_perm_b32 v180, v213, v209, s53
    v_perm_b32 v182, v213, v209, s54
    v_perm_b32 v184, v214, v210, s53
    v_perm_b32 v186, v214, v210, s54
    v_perm_b32 v188, v215, v211, s53
    v_perm_b32 v190, v215, v211, s54
    buffer_load_dwordx4 v[76:79], v8, s[24:27], s57 offen offset:1152 nt
    s_waitcnt vmcnt(5)
    buffer_load_dwordx4 v[80:83], v8, s[24:27], s57 offen offset:2048 nt
    s_waitcnt vmcnt(5)
    v_perm_b32 v177, v220, v216, s53
    v_perm_b32 v179, v220, v216, s54
    v_perm_b32 v181, v221, v217, s53
    v_perm_b32 v183, v221, v217, s54
    v_perm_b32 v185, v222, v218, s53
    v_perm_b32 v187, v222, v218, s54
    v_perm_b32 v189, v223, v219, s53
    v_perm_b32 v191, v223, v219, s54
    s_waitcnt lgkmcnt(0)
    v_mfma_f32_16x16x16_bf16 v[224:227], v[34:35], v[176:177], 0
    v_mfma_f32_16x16x16_bf16 v[228:231], v[34:35], v[178:179], 0
    v_mfma_f32_16x16x16_bf16 v[232:235], v[34:35], v[180:181], 0
    v_mfma_f32_16x16x16_bf16 v[236:239], v[34:35], v[182:183], 0
    v_mfma_f32_16x16x16_bf16 v[240:243], v[34:35], v[184:185], 0
    v_mfma_f32_16x16x16_bf16 v[244:247], v[34:35], v[186:187], 0
    v_mfma_f32_16x16x16_bf16 v[248:251], v[34:35], v[188:189], 0
    v_mfma_f32_16x16x16_bf16 v[252:255], v[34:35], v[190:191], 0
    s_mov_b64 exec, 0xff0000ff
    ds_write2_b32 v52, v224, v225 offset0:0 offset1:64
    ds_write2_b32 v52, v228, v229 offset0:1 offset1:65
    ds_write2_b32 v52, v232, v233 offset0:2 offset1:66
    ds_write2_b32 v52, v236, v237 offset0:3 offset1:67
    ds_write2_b32 v52, v240, v241 offset0:4 offset1:68
    ds_write2_b32 v52, v244, v245 offset0:5 offset1:69
    ds_write2_b32 v52, v248, v249 offset0:6 offset1:70
    ds_write2_b32 v52, v252, v253 offset0:7 offset1:71
    s_mov_b64 exec, -1
    buffer_load_dwordx4 v[84:87], v8, s[24:27], s57 offen offset:2176 nt
    v_readfirstlane_b32 s52, v15
    v_and_b32 v48, 7, v0
    v_mul_u32_u24 v48, 576, v48
    v_bfe_u32 v51, v0, 3, 5
    v_lshl_add_u32 v48, v51, 4, v48
    s_lshr_b32 s6, s3, 2
    s_mul_i32 s6, s6, 9216
    s_add_u32 s6, s6, 12288
    v_add_u32 v48, s6, v48
    v_and_b32 v51, 15, v51
    s_add_u32 s52, s52, 0x9E3779B9
    s_lshr_b32 s70, s52, 11
    s_and_b32 s70, s70, 0xff
    s_movk_i32 s6, 1024
    s_movk_i32 s66, 16384
    s_cmp_ge_u32 s3, 4
    s_cselect_b32 s6, 896, s6
    s_cselect_b32 s7, s60, s59
    s_cselect_b32 s66, 32768, s66
    s_lshl_b32 s7, s7, 4
    s_add_u32 s66, s66, s7
    s_and_b32 s7, s4, 6
    s_bfe_u32 s67, s3, 0x10001
    s_add_u32 s7, s7, s67
    s_mul_i32 s6, s6, s7
    s_add_u32 s66, s66, s6
    s_cmp_ge_u32 s73, 28
    s_cselect_b32 s6, 4, 8
    s_cmp_lt_u32 s3, s6
    s_cselect_b32 s7, 1, 0
    v_add_lshl_u32 v51, v51, s66, 4
    s_waitcnt lgkmcnt(0)
    s_barrier
    s_cmp_eq_u32 s7, 0
    s_cbranch_scc1 L_st2q
    ds_read_b128 v[224:227], v48
    ds_read_b128 v[228:231], v48 offset:4608
    v_mov_b32 v235, s52
    s_mov_b32 s6, 0x07060503
    s_mov_b32 s7, 0x07060502
    s_mov_b32 s66, 0x07060501
    s_waitcnt lgkmcnt(0)
    v_add_f32 v224, v224, v228
    v_add_f32 v225, v225, v229
    v_add_f32 v226, v226, v230
    v_add_f32 v227, v227, v231
    v_add_f32_dpp v224, v224, v224 quad_perm:[1,0,3,2] row_mask:0xf bank_mask:0xf
    v_add_f32_dpp v225, v225, v225 quad_perm:[1,0,3,2] row_mask:0xf bank_mask:0xf
    v_add_f32_dpp v226, v226, v226 quad_perm:[1,0,3,2] row_mask:0xf bank_mask:0xf
    v_add_f32_dpp v227, v227, v227 quad_perm:[1,0,3,2] row_mask:0xf bank_mask:0xf
    v_add_f32_dpp v224, v224, v224 quad_perm:[2,3,0,1] row_mask:0xf bank_mask:0xf
    v_add_f32_dpp v225, v225, v225 quad_perm:[2,3,0,1] row_mask:0xf bank_mask:0xf
    v_add_f32_dpp v226, v226, v226 quad_perm:[2,3,0,1] row_mask:0xf bank_mask:0xf
    v_add_f32_dpp v227, v227, v227 quad_perm:[2,3,0,1] row_mask:0xf bank_mask:0xf
    v_add_f32_dpp v224, v224, v224 row_half_mirror row_mask:0xf bank_mask:0xf
    v_add_f32_dpp v225, v225, v225 row_half_mirror row_mask:0xf bank_mask:0xf
    v_add_f32_dpp v226, v226, v226 row_half_mirror row_mask:0xf bank_mask:0xf
    v_add_f32_dpp v227, v227, v227 row_half_mirror row_mask:0xf bank_mask:0xf
    v_add_u32 v224, 0x80, v224
    v_add_u32 v225, 0x80, v225
    v_add_u32 v226, 0x80, v226
    v_add_u32 v227, 0x80, v227
    v_perm_b32 v232, v224, v227, s6
    v_perm_b32 v233, v225, v227, s7
    v_perm_b32 v234, v226, v227, s66
    s_mov_b32 exec_lo, 0x01010101
    s_mov_b32 exec_hi, 0x01010101
    buffer_store_dwordx4 v[232:235], v51, s[12:15], 0 offen sc1
    s_mov_b64 exec, -1
L_st2q:
    s_getreg_b32 s72, hwreg(HW_REG_XCC_ID, 0, 4)
    s_lshl_b32 s6, s4, 5
    s_add_u32 s6, s6, 256
    v_and_b32 v22, 31, v1
    v_add_lshl_u32 v22, v22, s6, 4
    s_cmp_lg_u32 s3, 7
    s_cbranch_scc1 L_noxg
    s_add_u32 s6, s6, s5
    s_lshl_b32 s6, s6, 4
    v_mov_b32 v48, s6
    v_mov_b32 v240, s72
    v_mov_b32 v241, s52
    v_mov_b32 v242, s72
    v_mov_b32 v243, s52
    s_mov_b64 exec, 1
    buffer_store_dwordx4 v[240:243], v48, s[12:15], 0 offen sc1
    s_mov_b64 exec, -1
L_noxg:
    s_waitcnt vmcnt(5)
    buffer_load_dwordx4 v[88:91], v8, s[24:27], s57 offen offset:3072 nt
    s_lshl_b32 s6, s4, 3
    s_add_u32 s6, s6, s3
    s_lshl_b32 s6, s6, 5
    s_add_u32 s6, s6, 16384
    v_lshrrev_b32 v52, 5, v1
    v_and_b32 v20, 31, v1
    v_lshl_add_u32 v20, v52, 12, v20
    v_add_lshl_u32 v20, v20, s6, 4
    s_lshl_b32 s6, s73, 3
    s_add_u32 s6, s6, s3
    s_lshl_b32 s7, s79, 8
    s_mov_b32 s59, s71
    s_lshl_b32 s60, s6, 15
    s_add_u32 s60, s60, s7
    s_add_u32 s80, s60, 4096
    s_min_u32 s6, s6, 223
    s_lshl_b32 s6, s6, 2
    v_bfe_u32 v48, v1, 2, 2
    v_add_u32 v48, s6, v48
    v_and_b32 v49, 3, v1
    v_bfe_u32 v50, v1, 4, 1
    v_lshl_add_u32 v49, v49, 1, v50
    v_mul_u32_u24 v49, 896, v49
    v_add_u32 v21, v49, v48
    v_add_u32 v21, 32768, v21
    v_lshlrev_b32 v21, 4, v21
    v_lshl_add_u32 v48, v48, 1, v52
    v_lshlrev_b32 v48, 2, v48
    v_bfe_u32 v50, v1, 1, 2
    v_lshlrev_b32 v50, 1, v50
    s_lshl_b32 s6, s5, 3
    s_add_u32 s6, s6, s7
    v_add_u32 v50, s6, v50
    v_and_b32 v51, 1, v1
    v_lshl_add_u32 v5, v51, 11, v50
    buffer_load_dword v16, v48, s[40:43], 0 offen
    buffer_load_ushort v19, v50, s[44:47], 0 offen
    buffer_load_ushort v18, v5, s[8:11], 0 offen
    s_waitcnt vmcnt(8)
    buffer_load_dwordx4 v[92:95], v8, s[24:27], s57 offen offset:3200 nt
    s_waitcnt vmcnt(8)
    buffer_load_dwordx4 v[96:99], v8, s[24:27], s58 offen offset:0 nt
    s_waitcnt vmcnt(8)
    buffer_load_dwordx4 v[100:103], v8, s[24:27], s58 offen offset:128 nt
    s_waitcnt vmcnt(8)
    buffer_load_dwordx4 v[104:107], v8, s[24:27], s58 offen offset:1024 nt
    s_waitcnt vmcnt(8)
    buffer_load_dwordx4 v[108:111], v8, s[24:27], s58 offen offset:1152 nt
    s_waitcnt vmcnt(8)
    buffer_load_dwordx4 v[112:115], v8, s[24:27], s58 offen offset:2048 nt
    s_waitcnt vmcnt(5)
    buffer_load_dwordx4 v[116:119], v8, s[24:27], s58 offen offset:2176 nt
    s_waitcnt vmcnt(5)
    buffer_load_dwordx4 v[120:123], v8, s[24:27], s58 offen offset:3072 nt
    buffer_load_dwordx4 v[192:195], v20, s[12:15], 0 offen sc1
    s_waitcnt vmcnt(6)
    buffer_load_dwordx4 v[124:127], v8, s[24:27], s58 offen offset:3200 nt
    s_mov_b32 s6, 0x8000
    buffer_load_dwordx4 v[196:199], v20, s[12:15], s6 offen sc1
    s_waitcnt vmcnt(7)
    buffer_load_dwordx4 v[128:131], v9, s[28:31], s57 offen offset:0 nt
    buffer_load_dwordx4 v[200:203], v21, s[12:15], 0 offen sc1
    buffer_load_dwordx4 v[204:207], v22, s[12:15], 0 offen sc1
    s_waitcnt vmcnt(9)
    buffer_load_dwordx4 v[132:135], v9, s[28:31], s57 offen offset:1024 nt
    s_waitcnt vmcnt(9)
    buffer_load_dwordx4 v[136:139], v9, s[28:31], s57 offen offset:2048 nt
    s_waitcnt vmcnt(9)
    buffer_load_dwordx4 v[140:143], v9, s[28:31], s57 offen offset:3072 nt
    s_waitcnt vmcnt(9)
    buffer_load_dwordx4 v[144:147], v9, s[28:31], s58 offen offset:0 nt
    s_waitcnt vmcnt(4)
    s_mov_b32 s63, 0
L_qg_check:
    v_xor_b32 v48, s52, v195
    v_xor_b32 v49, s52, v199
    v_xor_b32 v50, s52, v203
    v_or3_b32 v48, v48, v49, v50
    v_xor_b32 v49, s52, v205
    v_xor_b32 v50, s52, v207
    v_or3_b32 v48, v48, v49, v50
    v_cmp_ne_u32 vcc, 0, v48
    s_nop 0
    s_and_b64 exec, exec, vcc
    s_cbranch_execz L_qg_ok
    s_add_u32 s63, s63, 1
    s_cmp_gt_u32 s63, 100000
    s_cbranch_scc1 L_qg_ok
    buffer_load_dwordx4 v[192:195], v20, s[12:15], 0 offen sc1
    s_mov_b32 s6, 0x8000
    buffer_load_dwordx4 v[196:199], v20, s[12:15], s6 offen sc1
    buffer_load_dwordx4 v[200:203], v21, s[12:15], 0 offen sc1
    buffer_load_dwordx4 v[204:207], v22, s[12:15], 0 offen sc1
    s_waitcnt vmcnt(0)
    s_branch L_qg_check
L_qg_ok:
    s_mov_b64 exec, -1
    v_cmp_ne_u32 vcc, s72, v204
    s_mov_b32 s6, 0x04000c0c
    s_mov_b32 s7, 0x0706000c
    s_cmp_eq_u64 vcc, 0
    s_cselect_b32 s81, 1, 0
    v_perm_b32 v195, v192, v193, s6
    v_perm_b32 v195, v195, v194, s7
    v_and_b32 v192, 0xffffff00, v192
    v_and_b32 v193, 0xffffff00, v193
    v_and_b32 v194, 0xffffff00, v194
    v_perm_b32 v199, v196, v197, s6
    v_perm_b32 v199, v199, v198, s7
    v_and_b32 v196, 0xffffff00, v196
    v_and_b32 v197, 0xffffff00, v197
    v_and_b32 v198, 0xffffff00, v198
    v_perm_b32 v203, v200, v201, s6
    v_perm_b32 v203, v203, v202, s7
    v_and_b32 v200, 0xffffff00, v200
    v_and_b32 v201, 0xffffff00, v201
    v_and_b32 v202, 0xffffff00, v202
    v_add_f32 v192, v192, v196
    v_add_f32 v193, v193, v197
    v_add_f32 v194, v194, v198
    v_add_f32 v195, v195, v199
    v_cmp_lt_u32 vcc, 31, v1
    v_and_b32 v50, 31, v1
    v_lshrrev_b32 v51, 5, v1
    v_permlane32_swap_b32 v192, v194
    v_permlane32_swap_b32 v193, v195
    v_lshl_add_u32 v50, v50, 1, v51
    s_lshl_b32 s6, s3, 6
    v_add_lshl_u32 v50, v50, s6, 2
    v_add_f32 v192, v192, v194
    v_add_f32 v193, v193, v195
    v_cndmask_b32 v208, v200, v202, vcc
    v_cndmask_b32 v210, v201, v203, vcc
    v_cvt_pk_bf16_f32 v192, v192, v193
    ds_write_b32 v50, v192 offset:10240
    v_and_b32 v48, 7, v1
    v_lshlrev_b32 v48, 8, v48
    v_bfe_u32 v49, v1, 3, 1
    v_lshl_add_u32 v48, v49, 6, v48
    v_lshl_add_u32 v48, v2, 4, v48
    v_bfe_u32 v56, v1, 2, 3
    v_lshl_add_u32 v56, v56, 1, v51
    v_lshlrev_b32 v56, 2, v56
    v_add_u32 v56, s6, v56
    v_lshlrev_b32 v57, 5, v49
    v_lshl_add_u32 v57, v2, 3, v57
    v_add_u32 v57, s6, v57
    v_add_f32_dpp v208, v208, v208 quad_perm:[1,0,3,2] row_mask:0xf bank_mask:0xf
    v_add_f32_dpp v210, v210, v210 quad_perm:[1,0,3,2] row_mask:0xf bank_mask:0xf
    s_nop 0
    v_add_f32_dpp v208, v208, v208 quad_perm:[2,3,0,1] row_mask:0xf bank_mask:0xf
    v_add_f32_dpp v210, v210, v210 quad_perm:[2,3,0,1] row_mask:0xf bank_mask:0xf
    v_lshlrev_b32 v40, 16, v16
    v_and_b32 v41, 0xffff0000, v16
    v_cvt_pk_bf16_f32 v209, v208, v210
    v_lshlrev_b32 v208, 16, v209
    v_and_b32 v210, 0xffff0000, v209
    v_add_f32 v208, v208, v40
    v_add_f32 v210, v210, v41
    v_cvt_pk_bf16_f32 v209, v208, v210
    s_mov_b32 s6, 0xbdd2d3e8
    v_mov_b32 v211, 0xc0135761
    v_lshlrev_b32 v208, 16, v209
    v_and_b32 v210, 0xffff0000, v209
    v_mul_f32 v40, v208, v208
    v_mul_f32 v41, v210, v210
    v_fma_f32 v40, v40, s6, v211
    v_fma_f32 v41, v41, s6, v211
    v_mul_f32 v40, v40, v208
    v_mul_f32 v41, v41, v210
    v_exp_f32 v40, v40
    v_exp_f32 v41, v41
    v_add_f32 v40, 1.0, v40
    v_add_f32 v41, 1.0, v41
    v_rcp_f32 v40, v40
    v_rcp_f32 v41, v41
    v_mul_f32 v208, v208, v40
    v_mul_f32 v210, v210, v41
    v_cvt_pk_bf16_f32 v209, v208, v210
    ds_write_b32 v56, v209 offset:8704
    buffer_load_dwordx4 v[148:151], v9, s[28:31], s58 offen offset:1024 nt
    buffer_load_dwordx4 v[152:155], v9, s[28:31], s58 offen offset:2048 nt
    s_waitcnt lgkmcnt(0)
    s_barrier
    ds_read_b128 v[24:27], v48 offset:10240
    ds_read_b128 v[28:31], v48 offset:10368
    ds_read_b64 v[32:33], v57 offset:8704
    s_waitcnt lgkmcnt(0)
    v_mfma_f32_16x16x32_bf16 v[224:227], v[64:67], v[24:27], 0
    v_mfma_f32_16x16x32_bf16 v[228:231], v[72:75], v[24:27], 0
    v_mfma_f32_16x16x32_bf16 v[232:235], v[80:83], v[24:27], 0
    v_mfma_f32_16x16x32_bf16 v[236:239], v[88:91], v[24:27], 0
    v_mfma_f32_16x16x32_bf16 v[240:243], v[96:99], v[24:27], 0
    v_mfma_f32_16x16x32_bf16 v[244:247], v[104:107], v[24:27], 0
    v_mfma_f32_16x16x32_bf16 v[248:251], v[112:115], v[24:27], 0
    v_mfma_f32_16x16x32_bf16 v[252:255], v[120:123], v[24:27], 0
    v_mfma_f32_16x16x32_bf16 v[224:227], v[68:71], v[28:31], v[224:227]
    v_mfma_f32_16x16x32_bf16 v[228:231], v[76:79], v[28:31], v[228:231]
    v_mfma_f32_16x16x32_bf16 v[232:235], v[84:87], v[28:31], v[232:235]
    v_mfma_f32_16x16x32_bf16 v[236:239], v[92:95], v[28:31], v[236:239]
    v_mfma_f32_16x16x32_bf16 v[240:243], v[100:103], v[28:31], v[240:243]
    v_mfma_f32_16x16x32_bf16 v[244:247], v[108:111], v[28:31], v[244:247]
    v_mfma_f32_16x16x32_bf16 v[248:251], v[116:119], v[28:31], v[248:251]
    v_mfma_f32_16x16x32_bf16 v[252:255], v[124:127], v[28:31], v[252:255]
    s_cmp_lt_u32 s73, 28
    s_cbranch_scc1 L_nohubperm
    v_mov_b32 v96, v176
    v_mov_b32 v97, v177
    v_mov_b32 v100, v178
    v_mov_b32 v101, v179
    v_mov_b32 v104, v180
    v_mov_b32 v105, v181
    v_mov_b32 v108, v182
    v_mov_b32 v109, v183
    v_mov_b32 v98, v184
    v_mov_b32 v99, v185
    v_mov_b32 v102, v186
    v_mov_b32 v103, v187
    v_mov_b32 v106, v188
    v_mov_b32 v107, v189
    v_mov_b32 v110, v190
    v_mov_b32 v111, v191
L_nohubperm:
    v_and_b32 v49, 7, v1
    v_lshlrev_b32 v49, 2, v49
    v_add_f32_dpp v36, v225, v224 row_ror:8 row_mask:0xf bank_mask:0x3
    v_add_f32_dpp v37, v229, v228 row_ror:8 row_mask:0xf bank_mask:0x3
    v_add_f32_dpp v38, v233, v232 row_ror:8 row_mask:0xf bank_mask:0x3
    v_add_f32_dpp v39, v237, v236 row_ror:8 row_mask:0xf bank_mask:0x3
    v_add_f32_dpp v40, v241, v240 row_ror:8 row_mask:0xf bank_mask:0x3
    v_add_f32_dpp v41, v245, v244 row_ror:8 row_mask:0xf bank_mask:0x3
    v_add_f32_dpp v42, v249, v248 row_ror:8 row_mask:0xf bank_mask:0x3
    v_add_f32_dpp v43, v253, v252 row_ror:8 row_mask:0xf bank_mask:0x3
    v_add_f32_dpp v36, v226, v227 row_ror:8 row_mask:0xf bank_mask:0xc
    v_add_f32_dpp v37, v230, v231 row_ror:8 row_mask:0xf bank_mask:0xc
    v_add_f32_dpp v38, v234, v235 row_ror:8 row_mask:0xf bank_mask:0xc
    v_add_f32_dpp v39, v238, v239 row_ror:8 row_mask:0xf bank_mask:0xc
    v_add_f32_dpp v40, v242, v243 row_ror:8 row_mask:0xf bank_mask:0xc
    v_add_f32_dpp v41, v246, v247 row_ror:8 row_mask:0xf bank_mask:0xc
    v_add_f32_dpp v42, v250, v251 row_ror:8 row_mask:0xf bank_mask:0xc
    v_add_f32_dpp v43, v254, v255 row_ror:8 row_mask:0xf bank_mask:0xc
    v_cvt_pk_bf16_f32 v224, v36, v37
    v_cvt_pk_bf16_f32 v225, v38, v39
    v_cvt_pk_bf16_f32 v226, v40, v41
    v_cvt_pk_bf16_f32 v227, v42, v43
    v_lshlrev_b32 v36, 16, v224
    v_and_b32 v37, 0xffff0000, v224
    v_lshlrev_b32 v38, 16, v225
    v_and_b32 v39, 0xffff0000, v225
    v_lshlrev_b32 v40, 16, v226
    v_and_b32 v41, 0xffff0000, v226
    v_lshlrev_b32 v42, 16, v227
    v_and_b32 v43, 0xffff0000, v227
    v_mul_f32 v36, 0x3db504f3, v36
    v_mul_f32 v37, 0x3db504f3, v37
    v_mul_f32 v38, 0x3db504f3, v38
    v_mul_f32 v39, 0x3db504f3, v39
    v_mul_f32 v40, 0x3db504f3, v40
    v_mul_f32 v41, 0x3db504f3, v41
    v_mul_f32 v42, 0x3db504f3, v42
    v_mul_f32 v43, 0x3db504f3, v43
    v_cvt_pk_bf16_f32 v224, v36, v37
    v_cvt_pk_bf16_f32 v225, v38, v39
    v_cvt_pk_bf16_f32 v226, v40, v41
    v_cvt_pk_bf16_f32 v227, v42, v43
    v_lshlrev_b32 v36, 16, v224
    v_and_b32 v37, 0xffff0000, v224
    v_lshlrev_b32 v38, 16, v225
    v_and_b32 v39, 0xffff0000, v225
    v_lshlrev_b32 v40, 16, v226
    v_and_b32 v41, 0xffff0000, v226
    v_lshlrev_b32 v42, 16, v227
    v_and_b32 v43, 0xffff0000, v227
    v_max3_f32 v48, v36, v37, v38
    v_max3_f32 v48, v48, v39, v40
    v_max3_f32 v48, v48, v41, v42
    v_max_f32 v48, v48, v43
    ds_max_f32 v49, v48 offset:8320
    s_waitcnt vmcnt(5)
    buffer_load_dwordx4 v[156:159], v9, s[28:31], s58 offen offset:3072 nt
    s_add_u32 s57, s57, 8192
    s_add_u32 s58, s58, 8192
    s_waitcnt vmcnt(5)
    buffer_load_dwordx4 v[160:163], v9, s[28:31], s57 offen offset:0 nt
    s_waitcnt lgkmcnt(0)
    s_barrier
    ds_read_b32 v48, v49 offset:8320
    s_waitcnt lgkmcnt(0)
    v_mul_f32 v48, s64, v48
    v_fma_f32 v36, v36, s64, -v48
    v_fma_f32 v37, v37, s64, -v48
    v_fma_f32 v38, v38, s64, -v48
    v_fma_f32 v39, v39, s64, -v48
    v_fma_f32 v40, v40, s64, -v48
    v_fma_f32 v41, v41, s64, -v48
    v_fma_f32 v42, v42, s64, -v48
    v_fma_f32 v43, v43, s64, -v48
    v_exp_f32 v36, v36
    v_exp_f32 v37, v37
    v_exp_f32 v38, v38
    v_exp_f32 v39, v39
    v_exp_f32 v40, v40
    v_exp_f32 v41, v41
    v_exp_f32 v42, v42
    v_exp_f32 v43, v43
    v_cvt_pk_bf16_f32 v44, v36, v37
    v_cvt_pk_bf16_f32 v45, v38, v39
    v_cvt_pk_bf16_f32 v46, v40, v41
    v_cvt_pk_bf16_f32 v47, v42, v43
    v_add_f32 v36, v36, v37
    v_add_f32 v38, v38, v39
    v_add_f32 v40, v40, v41
    v_add_f32 v42, v42, v43
    v_mov_b32 v24, v44
    v_mov_b32 v25, v45
    v_mov_b32 v26, v46
    v_mov_b32 v27, v47
    v_mov_b32_dpp v24, v44 row_ror:8 row_mask:0xf bank_mask:0x3
    v_mov_b32_dpp v25, v45 row_ror:8 row_mask:0xf bank_mask:0x3
    v_mov_b32_dpp v26, v46 row_ror:8 row_mask:0xf bank_mask:0x3
    v_mov_b32_dpp v27, v47 row_ror:8 row_mask:0xf bank_mask:0x3
    v_mov_b32_dpp v44, v44 row_ror:8 row_mask:0xf bank_mask:0xc
    v_mov_b32_dpp v45, v45 row_ror:8 row_mask:0xf bank_mask:0xc
    v_mov_b32_dpp v46, v46 row_ror:8 row_mask:0xf bank_mask:0xc
    v_mov_b32_dpp v47, v47 row_ror:8 row_mask:0xf bank_mask:0xc
    v_add_f32 v36, v36, v38
    v_add_f32 v40, v40, v42
    v_add_f32 v36, v36, v40
    s_nop 1
    v_add_f32_dpp v36, v36, v36 row_ror:8 row_mask:0xf bank_mask:0xf
    v_mov_b32 v37, v36
    s_nop 1
    v_permlane16_swap_b32 v36, v37
    v_add_f32 v36, v36, v37
    v_mov_b32 v37, v36
    s_nop 1
    v_permlane32_swap_b32 v36, v37
    v_add_f32 v36, v36, v37
    s_lshl_b32 s6, s3, 2
    v_lshlrev_b32 v50, 3, v49
    v_add_u32 v50, s6, v50
    ds_write_b32 v50, v36 offset:8448
    s_waitcnt vmcnt(5)
    buffer_load_dwordx4 v[164:167], v9, s[28:31], s57 offen offset:1024 nt
    s_waitcnt vmcnt(5)
    buffer_load_dwordx4 v[168:171], v9, s[28:31], s57 offen offset:2048 nt
    v_and_b32 v50, 7, v1
    v_mul_u32_u24 v50, 528, v50
    v_lshl_add_u32 v50, v2, 7, v50
    v_bfe_u32 v48, v1, 3, 1
    v_lshl_add_u32 v50, v48, 6, v50
    s_mul_i32 s6, s3, 4256
    s_add_u32 s6, s6, 30720
    v_add_u32 v50, s6, v50
    v_and_b32 v49, 1, v1
    v_mul_u32_u24 v51, 17024, v49
    v_lshrrev_b32 v52, 1, v1
    v_lshl_add_u32 v51, v52, 4, v51
    s_mul_i32 s6, s3, 528
    s_add_u32 s6, s6, 30720
    v_add_u32 v51, s6, v51
    s_lshl_b32 s65, s4, 5
    s_add_u32 s65, s65, s5
    s_lshl_b32 s6, s65, 3
    s_add_u32 s6, s6, s3
    s_lshl_b32 s6, s6, 5
    s_add_u32 s6, s6, 65536
    v_add_lshl_u32 v52, v52, s6, 4
    s_lshl_b32 s6, s3, 5
    v_mov_b32 v53, s6
    s_lshl_b32 s6, s3, 2
    v_mov_b32 v54, s6
    ds_read_b32 v54, v54 offset:8320
    s_lshl_b32 s6, s4, 6
    s_add_u32 s6, s6, s5
    s_lshl_b32 s6, s6, 3
    s_add_u32 s6, s6, s3
    s_lshl_b32 s6, s6, 3
    s_add_u32 s6, s6, 196608
    v_lshl_add_u32 v20, v48, 11, v2
    v_add_lshl_u32 v20, v20, s6, 4
    s_lshl_b32 s6, s4, 13
    s_and_b32 s7, s73, 3
    s_lshl_b32 s7, s7, 3
    s_add_u32 s7, s7, s3
    s_lshl_b32 s7, s7, 3
    s_add_u32 s6, s6, s7
    s_add_u32 s6, s6, 65536
    v_lshrrev_b32 v61, 5, v1
    v_and_b32 v60, 3, v1
    v_lshl_add_u32 v61, v61, 2, v60
    v_bfe_u32 v60, v1, 2, 3
    v_lshl_add_u32 v55, v60, 8, v61
    v_add_lshl_u32 v55, v55, s6, 4
    v_and_b32 v62, 4, v61
    v_add_u32 v61, v61, v62
    v_lshl_add_u32 v61, v60, 12, v61
    v_and_b32 v60, 7, v1
    s_lshl_b32 s6, s4, 8
    s_add_u32 s6, s6, s7
    s_lshl_b32 s6, s6, 1
    s_add_u32 s6, s6, 196608
    v_add_lshl_u32 v21, v61, s6, 4
    v_lshrrev_b32 v56, 5, v1
    v_mul_u32_u24 v56, 544, v56
    v_lshl_add_u32 v56, v3, 5, v56
    v_and_b32 v61, 16, v1
    s_mul_i32 s6, s3, 1104
    s_add_u32 s6, s6, 64768
    v_add3_u32 v56, v56, v61, s6
    v_mul_u32_u24 v57, 4416, v49
    v_bfe_u32 v61, v0, 1, 1
    v_mul_u32_u24 v61, 544, v61
    v_and_b32 v62, 0x1fc, v0
    v_add3_u32 v57, v57, v61, v62
    v_add_u32 v57, 64768, v57
    v_lshrrev_b32 v58, 1, v0
    v_lshlrev_b32 v58, 4, v58
    s_lshl_b32 s65, s65, 12
    s_add_u32 s65, s65, 2097152
    s_lshl_b32 s6, s4, 13
    s_lshl_b32 s7, s5, 3
    s_add_u32 s6, s6, s7
    s_add_u32 s6, s6, 131072
    v_lshrrev_b32 v59, 3, v1
    v_lshl_add_u32 v59, v59, 8, v60
    v_add_lshl_u32 v59, v59, s6, 4
    s_mov_b32 s68, 0xf0f0f0f0
    s_mov_b32 s69, 0xf0f0f0f0
    s_mov_b32 s74, 0xff00ff00
    s_mov_b32 s75, 0xff00ff00
    s_mov_b32 s66, 0x55555555
    s_mov_b32 s67, 0x55555555
    s_movk_i32 s62, 0xff
    s_mov_b32 s76, 0x8000
    s_mov_b32 s77, 0x10000
    s_mov_b32 s78, 0x18000
    v_mov_b32 v224, 0
    v_mov_b32 v225, 0
    v_mov_b32 v226, 0
    v_mov_b32 v227, 0
    ds_write_b128 v56, v[224:227] offset:8832
    v_perm_b32 v64, v132, v128, s53
    v_perm_b32 v68, v132, v128, s54
    v_perm_b32 v72, v133, v129, s53
    v_perm_b32 v76, v133, v129, s54
    v_perm_b32 v80, v134, v130, s53
    v_perm_b32 v84, v134, v130, s54
    v_perm_b32 v88, v135, v131, s53
    v_perm_b32 v92, v135, v131, s54
    v_perm_b32 v65, v140, v136, s53
    v_perm_b32 v69, v140, v136, s54
    v_perm_b32 v73, v141, v137, s53
    v_perm_b32 v77, v141, v137, s54
    v_perm_b32 v81, v142, v138, s53
    v_perm_b32 v85, v142, v138, s54
    v_perm_b32 v89, v143, v139, s53
    v_perm_b32 v93, v143, v139, s54
    s_waitcnt vmcnt(5)
    v_perm_b32 v66, v148, v144, s53
    v_perm_b32 v70, v148, v144, s54
    v_perm_b32 v74, v149, v145, s53
    v_perm_b32 v78, v149, v145, s54
    v_perm_b32 v82, v150, v146, s53
    v_perm_b32 v86, v150, v146, s54
    v_perm_b32 v90, v151, v147, s53
    v_perm_b32 v94, v151, v147, s54
    buffer_load_dwordx4 v[172:175], v9, s[28:31], s57 offen offset:3072 nt
    s_waitcnt vmcnt(5)
    buffer_load_dwordx4 v[176:179], v9, s[28:31], s58 offen offset:0 nt
    s_waitcnt vmcnt(5)
    v_perm_b32 v67, v156, v152, s53
    v_perm_b32 v71, v156, v152, s54
    v_perm_b32 v75, v157, v153, s53
    v_perm_b32 v79, v157, v153, s54
    v_perm_b32 v83, v158, v154, s53
    v_perm_b32 v87, v158, v154, s54
    v_perm_b32 v91, v159, v155, s53
    v_perm_b32 v95, v159, v155, s54
    v_mfma_f32_16x16x32_bf16 v[128:131], v[64:67], v[44:47], 0
    v_mfma_f32_16x16x32_bf16 v[132:135], v[68:71], v[44:47], 0
    v_mfma_f32_16x16x32_bf16 v[136:139], v[72:75], v[44:47], 0
    v_mfma_f32_16x16x32_bf16 v[140:143], v[76:79], v[44:47], 0
    v_mfma_f32_16x16x32_bf16 v[144:147], v[80:83], v[44:47], 0
    v_mfma_f32_16x16x32_bf16 v[148:151], v[84:87], v[44:47], 0
    v_mfma_f32_16x16x32_bf16 v[152:155], v[88:91], v[44:47], 0
    v_mfma_f32_16x16x32_bf16 v[156:159], v[92:95], v[44:47], 0
    buffer_load_dwordx4 v[180:183], v9, s[28:31], s58 offen offset:1024 nt
    s_waitcnt vmcnt(5)
    buffer_load_dwordx4 v[184:187], v9, s[28:31], s58 offen offset:2048 nt
    s_waitcnt vmcnt(5)
    v_perm_b32 v64, v164, v160, s53
    v_perm_b32 v68, v164, v160, s54
    v_perm_b32 v72, v165, v161, s53
    v_perm_b32 v76, v165, v161, s54
    v_perm_b32 v80, v166, v162, s53
    v_perm_b32 v84, v166, v162, s54
    v_perm_b32 v88, v167, v163, s53
    v_perm_b32 v92, v167, v163, s54
    buffer_load_dwordx4 v[188:191], v9, s[28:31], s58 offen offset:3072 nt
    s_waitcnt vmcnt(4)
    v_perm_b32 v65, v172, v168, s53
    v_perm_b32 v69, v172, v168, s54
    v_perm_b32 v73, v173, v169, s53
    v_perm_b32 v77, v173, v169, s54
    v_perm_b32 v81, v174, v170, s53
    v_perm_b32 v85, v174, v170, s54
    v_perm_b32 v89, v175, v171, s53
    v_perm_b32 v93, v175, v171, s54
    s_waitcnt vmcnt(2)
    v_perm_b32 v66, v180, v176, s53
    v_perm_b32 v70, v180, v176, s54
    v_perm_b32 v74, v181, v177, s53
    v_perm_b32 v78, v181, v177, s54
    v_perm_b32 v82, v182, v178, s53
    v_perm_b32 v86, v182, v178, s54
    v_perm_b32 v90, v183, v179, s53
    v_perm_b32 v94, v183, v179, s54
    buffer_load_dwordx4 v[208:211], v10, s[36:39], s60 offen offset:0 nt
    s_waitcnt vmcnt(2)
    buffer_load_dwordx4 v[212:215], v10, s[36:39], s60 offen offset:2048 nt
    s_waitcnt vmcnt(2)
L_tail_begin:
    v_perm_b32 v67, v188, v184, s53
    v_perm_b32 v83, v190, v186, s53
    v_perm_b32 v71, v188, v184, s54
    v_mfma_f32_16x16x32_bf16 v[128:131], v[64:67], v[24:27], v[128:131]
    v_perm_b32 v87, v190, v186, s54
    v_mfma_f32_16x16x32_bf16 v[144:147], v[80:83], v[24:27], v[144:147]
    v_perm_b32 v75, v189, v185, s53
    v_mfma_f32_16x16x32_bf16 v[132:135], v[68:71], v[24:27], v[132:135]
    v_perm_b32 v91, v191, v187, s53
    v_mfma_f32_16x16x32_bf16 v[148:151], v[84:87], v[24:27], v[148:151]
    v_perm_b32 v79, v189, v185, s54
    v_mfma_f32_16x16x32_bf16 v[136:139], v[72:75], v[24:27], v[136:139]
    v_perm_b32 v95, v191, v187, s54
    v_mfma_f32_16x16x32_bf16 v[152:155], v[88:91], v[24:27], v[152:155]
    v_mfma_f32_16x16x32_bf16 v[140:143], v[76:79], v[24:27], v[140:143]
    v_cndmask_b32_e64 v224, v128, v144, s[74:75]
    v_cndmask_b32_e64 v225, v129, v145, s[74:75]
    v_cndmask_b32_e64 v226, v130, v146, s[74:75]
    v_cndmask_b32_e64 v227, v131, v147, s[74:75]
    ds_write_b128 v50, v[224:227] offset:0
    v_mfma_f32_16x16x32_bf16 v[156:159], v[92:95], v[24:27], v[156:159]
    v_cndmask_b32_e64 v228, v132, v148, s[74:75]
    v_cndmask_b32_e64 v229, v133, v149, s[74:75]
    v_cndmask_b32_e64 v230, v134, v150, s[74:75]
    v_cndmask_b32_e64 v231, v135, v151, s[74:75]
    ds_write_b128 v50, v[228:231] offset:16
    v_cndmask_b32_e64 v232, v136, v152, s[74:75]
    v_cndmask_b32_e64 v233, v137, v153, s[74:75]
    v_cndmask_b32_e64 v234, v138, v154, s[74:75]
    v_cndmask_b32_e64 v235, v139, v155, s[74:75]
    ds_write_b128 v50, v[232:235] offset:32
    v_cndmask_b32_e64 v236, v140, v156, s[74:75]
    v_cndmask_b32_e64 v237, v141, v157, s[74:75]
    v_cndmask_b32_e64 v238, v142, v158, s[74:75]
    v_cndmask_b32_e64 v239, v143, v159, s[74:75]
    ds_write_b128 v50, v[236:239] offset:48
    v_mov_b32 v255, s52
    s_waitcnt lgkmcnt(0)
    s_barrier
    ds_read_b128 v[36:39], v53 offset:8448
    ds_read_b128 v[40:43], v53 offset:8464
    ds_read_b128 v[224:227], v51 offset:0
    ds_read_b128 v[228:231], v51 offset:4256
    ds_read_b128 v[232:235], v51 offset:8512
    ds_read_b128 v[236:239], v51 offset:12768
    s_waitcnt lgkmcnt(4)
    v_add_f32 v36, v36, v40
    v_add_f32 v37, v37, v41
    v_add_f32 v38, v38, v42
    v_add_f32 v39, v39, v43
    v_add_f32 v36, v36, v37
    v_add_f32 v38, v38, v39
    v_add_f32 v36, v36, v38
    v_rcp_f32 v53, v36
    v_log_f32 v36, v36
    s_waitcnt lgkmcnt(2)
    v_add_f32 v224, v224, v228
    v_add_f32 v225, v225, v229
    v_add_f32 v226, v226, v230
    v_add_f32 v227, v227, v231
    s_waitcnt lgkmcnt(0)
    v_add_f32 v232, v232, v236
    v_add_f32 v233, v233, v237
    v_add_f32 v234, v234, v238
    v_add_f32 v235, v235, v239
    v_add_f32 v224, v224, v232
    v_add_f32 v225, v225, v233
    v_add_f32 v226, v226, v234
    v_add_f32 v227, v227, v235
    v_fma_f32 v54, v54, s64, v36
    v_add_u32 v54, 0x80, v54
    v_add_f32_dpp v224, v224, v224 quad_perm:[1,0,3,2] row_mask:0xf bank_mask:0xf
    v_add_f32_dpp v225, v225, v225 quad_perm:[1,0,3,2] row_mask:0xf bank_mask:0xf
    v_add_f32_dpp v226, v226, v226 quad_perm:[1,0,3,2] row_mask:0xf bank_mask:0xf
    v_add_f32_dpp v227, v227, v227 quad_perm:[1,0,3,2] row_mask:0xf bank_mask:0xf
    v_and_b32 v54, 0xffffff00, v54
    v_or_b32 v254, s70, v54
    v_mul_f32 v224, v224, v53
    v_mul_f32 v225, v225, v53
    v_mul_f32 v226, v226, v53
    v_mul_f32 v227, v227, v53
    v_cvt_pk_bf16_f32 v252, v224, v225
    v_cvt_pk_bf16_f32 v253, v226, v227
    s_mov_b64 exec, s[66:67]
    s_cmp_eq_u32 s81, 0
    s_cbranch_scc1 L_opubn_g
    buffer_store_dwordx4 v[252:255], v52, s[12:15], 0 offen
    s_branch L_opubn_j
L_opubn_g:
    buffer_store_dwordx4 v[252:255], v52, s[12:15], 0 offen sc1
L_opubn_j:
    s_mov_b64 exec, -1
    v_mov_b32 v177, s52
    v_mov_b32 v179, s52
    v_lshlrev_b32 v19, 16, v19
    v_lshlrev_b32 v18, 16, v18
    s_cmp_ge_u32 s73, 28
    s_cbranch_scc1 L_hubpre
    s_barrier
    buffer_load_dwordx4 v[216:219], v10, s[36:39], s80 offen offset:0 nt
    buffer_load_dwordx4 v[220:223], v10, s[36:39], s80 offen offset:2048 nt
    buffer_load_dwordx4 v[192:195], v23, s[32:35], s59 offen nt
    s_add_u32 s59, s59, 16384
    buffer_load_dwordx4 v[196:199], v23, s[32:35], s59 offen nt
    s_add_u32 s59, s59, 16384
    buffer_load_dwordx4 v[200:203], v23, s[32:35], s59 offen nt
    s_add_u32 s59, s59, 16384
    buffer_load_dwordx4 v[204:207], v23, s[32:35], s59 offen nt
    buffer_load_dwordx4 v[184:187], v20, s[12:15], 0 offen sc1
    s_waitcnt vmcnt(8)
    v_perm_b32 v112, v212, v208, s53
    v_perm_b32 v116, v212, v208, s54
    v_perm_b32 v120, v213, v209, s53
    v_perm_b32 v124, v213, v209, s54
    v_perm_b32 v114, v214, v210, s53
    v_perm_b32 v118, v214, v210, s54
    v_perm_b32 v122, v215, v211, s53
    v_perm_b32 v126, v215, v211, s54
    s_waitcnt vmcnt(5)
    v_perm_b32 v113, v220, v216, s53
    v_perm_b32 v117, v220, v216, s54
    v_perm_b32 v121, v221, v217, s53
    v_perm_b32 v125, v221, v217, s54
    v_perm_b32 v115, v222, v218, s53
    v_perm_b32 v119, v222, v218, s54
    v_perm_b32 v123, v223, v219, s53
    v_perm_b32 v127, v223, v219, s54
    v_cndmask_b32_e64 v40, v32, 0, s[68:69]
    v_cndmask_b32_e64 v41, v33, 0, s[68:69]
    v_cndmask_b32_e64 v42, 0, v32, s[68:69]
    v_cndmask_b32_e64 v43, 0, v33, s[68:69]
    s_nop 1
    v_mfma_f32_16x16x32_bf16 v[224:227], v[40:43], v[112:115], 0
    v_mfma_f32_16x16x32_bf16 v[228:231], v[40:43], v[116:119], 0
    v_mfma_f32_16x16x32_bf16 v[232:235], v[40:43], v[120:123], 0
    v_mfma_f32_16x16x32_bf16 v[236:239], v[40:43], v[124:127], 0
    s_nop 5
    v_mov_b32 v225, v228
    v_mov_b32 v226, v232
    v_mov_b32 v227, v236
    ds_write_b128 v56, v[224:227] offset:8832
    s_waitcnt vmcnt(3)
    v_perm_b32 v96, v196, v192, s53
    v_perm_b32 v100, v196, v192, s54
    v_perm_b32 v104, v197, v193, s53
    v_perm_b32 v108, v197, v193, s54
    v_perm_b32 v98, v198, v194, s53
    v_perm_b32 v102, v198, v194, s54
    v_perm_b32 v106, v199, v195, s53
    v_perm_b32 v110, v199, v195, s54
    s_waitcnt vmcnt(1)
    v_perm_b32 v97, v204, v200, s53
    v_perm_b32 v101, v204, v200, s54
    v_perm_b32 v105, v205, v201, s53
    v_perm_b32 v109, v205, v201, s54
    v_perm_b32 v99, v206, v202, s53
    v_perm_b32 v103, v206, v202, s54
    v_perm_b32 v107, v207, v203, s53
    v_perm_b32 v111, v207, v203, s54
    s_branch L_join
L_hubpre:
    buffer_load_dwordx4 v[128:131], v55, s[12:15], 0 offen sc1
    buffer_load_dwordx4 v[132:135], v55, s[12:15], s76 offen sc1
    buffer_load_dwordx4 v[136:139], v55, s[12:15], s77 offen sc1
    buffer_load_dwordx4 v[140:143], v55, s[12:15], s78 offen sc1
    s_waitcnt vmcnt(0)
    s_mov_b32 s63, 0
L_og_check:
    v_cmp_ne_u32_e64 s[16:17], s52, v131
    v_cmp_ne_u32_e64 s[18:19], s52, v135
    v_cmp_ne_u32_e64 s[20:21], s52, v139
    v_cmp_ne_u32_e64 s[22:23], s52, v143
    s_or_b64 vcc, s[16:17], s[18:19]
    s_or_b64 s[74:75], s[20:21], s[22:23]
    s_or_b64 vcc, vcc, s[74:75]
    s_cbranch_scc0 L_og_ok
L_og_retry:
    s_add_u32 s63, s63, 1
    s_cmp_gt_u32 s63, 100000
    s_cbranch_scc1 L_og_go
    s_mov_b64 exec, s[16:17]
    s_cbranch_execz L_og_s0
    buffer_load_dwordx4 v[128:131], v55, s[12:15], 0 offen sc1
L_og_s0:
    s_mov_b64 exec, s[18:19]
    s_cbranch_execz L_og_s1
    buffer_load_dwordx4 v[132:135], v55, s[12:15], s76 offen sc1
L_og_s1:
    s_mov_b64 exec, s[20:21]
    s_cbranch_execz L_og_s2
    buffer_load_dwordx4 v[136:139], v55, s[12:15], s77 offen sc1
L_og_s2:
    s_mov_b64 exec, s[22:23]
    s_cbranch_execz L_og_s3
    buffer_load_dwordx4 v[140:143], v55, s[12:15], s78 offen sc1
L_og_s3:
    s_mov_b64 exec, -1
    s_waitcnt vmcnt(0)
    s_branch L_og_check
L_og_ok:
    v_xor_b32 v60, s70, v130
    v_xor_b32 v61, s70, v134
    v_xor_b32 v62, s70, v138
    v_xor_b32 v63, s70, v142
    v_or3_b32 v48, v60, v61, v62
    v_or_b32 v48, v48, v63
    v_and_b32 v48, 0xff, v48
    v_cmp_ne_u32_e64 s[16:17], 0, v48
    s_nop 0
    s_mov_b64 s[18:19], s[16:17]
    s_mov_b64 s[20:21], s[16:17]
    s_or_b64 s[22:23], s[16:17], s[16:17]
    s_cbranch_scc1 L_og_retry
L_og_go:
    v_max3_f32 v144, v60, v61, v62
    v_max_f32 v144, v144, v63
    v_lshlrev_b32 v156, 16, v128
    v_and_b32 v157, 0xffff0000, v128
    v_max_f32_dpp v144, v144, v144 row_ror:4 row_mask:0xf bank_mask:0xf
    v_lshlrev_b32 v158, 16, v129
    v_and_b32 v159, 0xffff0000, v129
    v_max_f32_dpp v144, v144, v144 row_ror:8 row_mask:0xf bank_mask:0xf
    v_mov_b32 v172, v144
    v_lshlrev_b32 v160, 16, v132
    v_and_b32 v161, 0xffff0000, v132
    v_permlane16_swap_b32 v144, v172
    v_max_f32 v144, v144, v172
    v_sub_f32 v146, v60, v144
    v_sub_f32 v147, v61, v144
    v_sub_f32 v148, v62, v144
    v_sub_f32 v149, v63, v144
    v_exp_f32 v146, v146
    v_lshlrev_b32 v162, 16, v133
    v_and_b32 v163, 0xffff0000, v133
    v_exp_f32 v147, v147
    v_lshlrev_b32 v164, 16, v136
    v_and_b32 v165, 0xffff0000, v136
    v_exp_f32 v148, v148
    v_lshlrev_b32 v166, 16, v137
    v_and_b32 v167, 0xffff0000, v137
    v_exp_f32 v149, v149
    v_lshlrev_b32 v168, 16, v140
    v_and_b32 v169, 0xffff0000, v140
    v_lshlrev_b32 v170, 16, v141
    v_and_b32 v171, 0xffff0000, v141
    v_add_f32 v145, v146, v147
    v_mul_f32 v150, v156, v146
    v_mul_f32 v151, v157, v146
    v_mul_f32 v152, v158, v146
    v_mul_f32 v153, v159, v146
    v_add_f32 v145, v145, v148
    v_fmac_f32 v150, v160, v147
    v_fmac_f32 v151, v161, v147
    v_fmac_f32 v152, v162, v147
    v_fmac_f32 v153, v163, v147
    v_add_f32 v145, v145, v149
    v_fmac_f32 v150, v164, v148
    v_fmac_f32 v151, v165, v148
    v_fmac_f32 v152, v166, v148
    v_fmac_f32 v153, v167, v148
    v_add_f32_dpp v145, v145, v145 row_ror:4 row_mask:0xf bank_mask:0xf
    v_fmac_f32 v150, v168, v149
    v_fmac_f32 v151, v169, v149
    v_fmac_f32 v152, v170, v149
    v_fmac_f32 v153, v171, v149
    v_add_f32_dpp v145, v145, v145 row_ror:8 row_mask:0xf bank_mask:0xf
    v_mov_b32 v172, v145
    v_add_f32_dpp v150, v150, v150 row_ror:4 row_mask:0xf bank_mask:0xf
    v_add_f32_dpp v151, v151, v151 row_ror:4 row_mask:0xf bank_mask:0xf
    v_add_f32_dpp v152, v152, v152 row_ror:4 row_mask:0xf bank_mask:0xf
    v_add_f32_dpp v153, v153, v153 row_ror:4 row_mask:0xf bank_mask:0xf
    v_permlane16_swap_b32 v145, v172
    v_add_f32 v145, v145, v172
    v_add_f32_dpp v150, v150, v150 row_ror:8 row_mask:0xf bank_mask:0xf
    v_add_f32_dpp v151, v151, v151 row_ror:8 row_mask:0xf bank_mask:0xf
    v_add_f32_dpp v152, v152, v152 row_ror:8 row_mask:0xf bank_mask:0xf
    v_add_f32_dpp v153, v153, v153 row_ror:8 row_mask:0xf bank_mask:0xf
    v_rcp_f32 v145, v145
    v_mov_b32 v174, s52
    v_mov_b32 v175, s52
    v_permlane16_swap_b32 v150, v152
    v_permlane16_swap_b32 v151, v153
    v_add_f32 v150, v150, v152
    v_add_f32 v151, v151, v153
    v_mul_f32 v150, v150, v145
    v_mul_f32 v151, v151, v145
    v_cvt_pk_bf16_f32 v172, v150, v151
    v_cvt_pk_bf16_f32 v173, v150, v151
    s_nop 1
    v_permlane16_swap_b32 v172, v173
    buffer_store_dwordx4 v[172:175], v21, s[12:15], 0 offen sc1
    s_mov_b64 exec, -1
    s_barrier
    buffer_load_dwordx4 v[184:187], v20, s[12:15], 0 offen sc1
L_join:
    s_mov_b32 s63, 0
L_of_check:
    s_waitcnt vmcnt(0)
    v_cmp_ne_u32 vcc, s52, v186
    v_cmp_ne_u32_e64 s[74:75], s52, v187
    s_nop 0
    s_or_b64 vcc, vcc, s[74:75]
    s_and_b64 exec, exec, vcc
    s_cbranch_execz L_of_ok
    s_add_u32 s63, s63, 1
    s_cmp_gt_u32 s63, 100000
    s_cbranch_scc1 L_of_ok
    buffer_load_dwordx4 v[184:187], v20, s[12:15], 0 offen sc1
    s_branch L_of_check
L_of_ok:
    s_mov_b64 exec, -1
    v_cndmask_b32_e64 v40, v184, 0, s[68:69]
    v_cndmask_b32_e64 v41, v185, 0, s[68:69]
    v_cndmask_b32_e64 v42, 0, v184, s[68:69]
    v_cndmask_b32_e64 v43, 0, v185, s[68:69]
    s_nop 1
    v_mfma_f32_16x16x32_bf16 v[224:227], v[40:43], v[96:99], 0
    v_mfma_f32_16x16x32_bf16 v[228:231], v[40:43], v[100:103], 0
    v_mfma_f32_16x16x32_bf16 v[232:235], v[40:43], v[104:107], 0
    v_mfma_f32_16x16x32_bf16 v[236:239], v[40:43], v[108:111], 0
    s_nop 5
    v_mov_b32 v225, v228
    v_mov_b32 v226, v232
    v_mov_b32 v227, v236
    ds_write_b128 v56, v[224:227] offset:0
    s_waitcnt lgkmcnt(0)
    s_barrier
    ds_read_b32 v160, v57 offset:0
    ds_read_b32 v161, v57 offset:1104
    ds_read_b32 v162, v57 offset:2208
    ds_read_b32 v163, v57 offset:3312
    ds_read_b32 v164, v57 offset:8832
    ds_read_b32 v165, v57 offset:9936
    ds_read_b32 v166, v57 offset:11040
    ds_read_b32 v167, v57 offset:12144
    s_waitcnt lgkmcnt(6)
    v_add_f32 v160, v160, v161
    s_waitcnt lgkmcnt(4)
    v_add_f32 v162, v162, v163
    v_add_f32 v160, v160, v162
    s_waitcnt lgkmcnt(2)
    v_add_f32 v164, v164, v165
    s_waitcnt lgkmcnt(0)
    v_add_f32 v166, v166, v167
    v_add_f32 v164, v164, v166
    v_add_f32_dpp v176, v160, v160 quad_perm:[1,0,3,2] row_mask:0xf bank_mask:0xf
    s_nop 0
    v_add_f32_dpp v178, v164, v164 quad_perm:[1,0,3,2] row_mask:0xf bank_mask:0xf
    s_mov_b64 exec, s[66:67]
    s_cmp_eq_u32 s81, 0
    s_cbranch_scc1 L_spub_g
    buffer_store_dwordx4 v[176:179], v58, s[12:15], s65 offen
    s_branch L_spub_j
L_spub_g:
    buffer_store_dwordx4 v[176:179], v58, s[12:15], s65 offen sc1
L_spub_j:
    s_mov_b64 exec, -1
    s_cmp_lg_u32 s3, 0
    s_cbranch_scc1 L_fin_done
    s_mov_b32 s63, 0
L_sg_load:
    buffer_load_dwordx4 v[64:67], v59, s[12:15], 0 offen sc1
    buffer_load_dwordx4 v[68:71], v59, s[12:15], s76 offen sc1
    buffer_load_dwordx4 v[72:75], v59, s[12:15], s77 offen sc1
    buffer_load_dwordx4 v[76:79], v59, s[12:15], s78 offen sc1
    s_waitcnt vmcnt(3)
    v_xor_b32 v49, s52, v65
    v_xor_b32 v50, s52, v67
    v_or_b32 v48, v49, v50
    s_waitcnt vmcnt(2)
    v_xor_b32 v49, s52, v69
    v_xor_b32 v50, s52, v71
    v_or3_b32 v48, v48, v49, v50
    s_waitcnt vmcnt(1)
    v_xor_b32 v49, s52, v73
    v_xor_b32 v50, s52, v75
    v_or3_b32 v48, v48, v49, v50
    s_waitcnt vmcnt(0)
    v_xor_b32 v49, s52, v77
    v_xor_b32 v50, s52, v79
    v_or3_b32 v48, v48, v49, v50
    v_cmp_ne_u32 vcc, 0, v48
    s_nop 0
    s_and_b64 exec, exec, vcc
    s_cbranch_execz L_sg_ok
    s_add_u32 s63, s63, 1
    s_cmp_le_u32 s63, 100000
    s_cbranch_scc1 L_sg_load
L_sg_ok:
    s_mov_b64 exec, -1
    v_add_f32 v64, v64, v68
    v_add_f32 v66, v66, v70
    v_add_f32 v72, v72, v76
    v_add_f32 v74, v74, v78
    v_add_f32 v64, v64, v72
    v_add_f32 v66, v66, v74
    s_nop 1
    v_permlane32_swap_b32 v64, v66
    v_add_f32 v64, v64, v66
    v_mov_b32 v68, v64
    s_nop 1
    v_permlane16_swap_b32 v64, v68
    v_add_f32 v64, v64, v68
    s_nop 1
    v_add_f32_dpp v64, v64, v64 row_ror:8 row_mask:0xf bank_mask:0xf
    v_cvt_pk_bf16_f32 v64, v64, v64
    v_and_b32 v64, 0xffff0000, v64
    v_mov_b32 v66, v64
    s_nop 1
    v_permlane32_swap_b32 v64, v66
    v_add_f32 v66, v66, v19
    v_cvt_pk_bf16_f32 v66, v66, v66
    v_and_b32 v66, 0xffff0000, v66
    v_mul_f32 v67, 0xbfb8aa3b, v66
    v_exp_f32 v67, v67
    s_nop 0
    v_add_f32 v67, 1.0, v67
    v_rcp_f32 v67, v67
    s_nop 0
    v_mul_f32 v66, v66, v67
    v_cvt_pk_bf16_f32 v66, v66, v66
    v_and_b32 v66, 0xffff0000, v66
    v_mul_f32 v64, v64, v66
    v_cvt_pk_bf16_f32 v64, v64, v64
    v_and_b32 v64, 0xffff0000, v64
    v_add_f32 v64, v64, v18
    v_cvt_pk_bf16_f32 v64, v64, v64
    s_mov_b64 exec, 0xff
    buffer_store_short v64, v5, s[48:51], 0 offen
    s_cmp_lg_u32 s2, 0
    s_cbranch_scc1 L_fin_done
    s_mov_b64 exec, 1
    v_mov_b32 v48, 0
    v_mov_b32 v49, s52
    buffer_store_dword v49, v48, s[12:15], 0 offen
L_fin_done:
L_end:
    s_endpgm
.section .rodata,"a"
.p2align 6
.amdhsa_kernel recurrent_scan__gqa_block_cached__mixer_channel_mlp__decode_kernel
  .amdhsa_next_free_vgpr 256
  .amdhsa_next_free_sgpr 102
  .amdhsa_accum_offset 256
  .amdhsa_group_segment_fixed_size 0
  .amdhsa_kernarg_size 104
  .amdhsa_user_sgpr_count 2
  .amdhsa_user_sgpr_kernarg_segment_ptr 1
  .amdhsa_system_sgpr_workgroup_id_x 1
.end_amdhsa_kernel
```
